```python
import torch

def _softmax(x, axis=-1):
    return torch.softmax(x, dim=axis)
def _gelu(x):
    return torch.nn.functional.gelu(x, approximate="tanh")
def _silu(x):
    return torch.nn.functional.silu(x)
def _sigmoid(x):
    return torch.sigmoid(x)
def _layernorm(x, axis=-1, eps=1e-5):
    m = x.mean(dim=axis, keepdim=True)
    v = x.var(dim=axis, keepdim=True, unbiased=False)
    return (x - m) / torch.sqrt(v + eps)
def _scatter_add(tgt, idx, src, axis=0):
    return tgt.clone().index_add_(axis, idx, src)
def _segment_sum(src, seg, n):
    out = torch.zeros((n,) + src.shape[1:], dtype=src.dtype)
    return out.index_add_(0, seg, src)
def _pad(x, pw):
    flat = tuple(v for pair in reversed(pw) for v in pair)
    return torch.nn.functional.pad(x, flat)

kernel_name = 'standalone__mha_softmax__sampling'

def setup_inputs():

    _w = (lambda a: (lambda t: t.to(torch.bfloat16) if t.is_floating_point() else t)(torch.as_tensor(a)))
    B, H, Sq, Sk, D = 8, 32, 4, 4096, 192
    return {
        "q": _w((lambda *s: torch.randn(*s, dtype=torch.bfloat16) * 0.8)(B, H, Sq, D)),
        "k": _w((lambda *s: torch.randn(*s, dtype=torch.bfloat16) * 0.8)(B, H, Sk, D)),
        "v": _w((lambda *s: torch.randn(*s, dtype=torch.bfloat16) * 0.05)(B, H, Sk, D)),
    }

def reference(q, k, v):
    scale = q.shape[-1] ** -0.5
    scores = torch.einsum("bhqd,bhkd->bhqk", q, k) * scale
    p = _softmax(scores, axis=-1)
    return torch.einsum("bhqk,bhkd->bhqd", p, v)
```

```asm
; @launch grid=(256,1,1) block=(320,1,1) lds=139392
.amdgcn_target "amdgcn-amd-amdhsa--gfx950"
.text
.globl standalone__mha_softmax__sampling_kernel
.p2align 8
.type standalone__mha_softmax__sampling_kernel,@function
standalone__mha_softmax__sampling_kernel:
    s_cmp_ge_u32 s2, 256
    s_cbranch_scc1 L_end
    s_load_dwordx4 s[4:7], s[0:1], 8
    s_load_dwordx2 s[36:37], s[0:1], 0
    s_load_dwordx2 s[38:39], s[0:1], 24
    v_lshrrev_b32 v1, 6, v0
    v_and_b32 v0, 63, v0
    s_mul_i32 s9, s2, 1572864
    v_readfirstlane_b32 s3, v1
    s_nop 3
    s_cmp_lg_u32 s3, 0
    s_cbranch_scc1 L_cons
    s_setprio 3
    v_lshlrev_b32 v1, 4, v0
    s_mul_i32 s21, s2, 21
    s_mov_b32 s40, 132096
    s_mov_b32 s41, 64512
    s_and_b32 s30, s21, 63
    s_bfe_u32 s31, s21, 0x20006
    s_mul_i32 s31, s31, 393216
    s_mul_i32 s35, s30, 3072
    s_cmp_ge_u32 s30, 21
    s_cselect_b32 s34, 67584, 0
    s_add_u32 s35, s35, s34
    s_cmp_ge_u32 s30, 42
    s_cselect_b32 s34, 67584, 0
    s_add_u32 s35, s35, s34
    s_cmp_eq_u32 s30, 63
    s_cselect_b32 s35, 129024, s35
    s_cselect_b32 s34, s40, s41
    s_add_u32 s35, s35, s31
    s_add_u32 s21, s21, 1
    s_mov_b32 s20, s35
    v_add_u32 v2, s34, v1
    s_mov_b32 s27, 0
    s_mov_b32 s23, -4
    s_mov_b32 s42, 0
    s_mov_b32 s43, 12
    s_waitcnt lgkmcnt(0)
    s_add_u32 s12, s4, s9
    s_addc_u32 s13, s5, 0
    s_mov_b32 s14, 1572864
    s_mov_b32 s15, 0x20000
L_ld:
    s_add_u32 m0, s27, 3072
    s_waitcnt vmcnt(18)
    buffer_load_dwordx4 v2, s[12:15], s20 offen offset:0 nt lds
    s_and_b32 s28, s23, 0x80000003
    s_cmp_lg_u32 s28, 3
    s_cbranch_scc1 L_ld_nb
    s_barrier
L_ld_nb:
    s_and_b32 s30, s21, 63
    s_bfe_u32 s31, s21, 0x20006
    s_mul_i32 s31, s31, 393216
    s_mul_i32 s35, s30, 3072
    s_mov_b32 m0, s27
    s_waitcnt vmcnt(18)
    buffer_load_dwordx4 v1, s[12:15], s20 offen offset:0 nt lds
    s_cmp_ge_u32 s30, 21
    s_cselect_b32 s34, 67584, 0
    s_add_u32 s35, s35, s34
    s_add_u32 m0, s27, 3072
    s_waitcnt vmcnt(18)
    buffer_load_dwordx4 v2, s[12:15], s20 offen offset:1024 nt lds
    s_cmp_ge_u32 s30, 42
    s_cselect_b32 s34, 67584, 0
    s_add_u32 s35, s35, s34
    s_mov_b32 m0, s27
    s_waitcnt vmcnt(18)
    buffer_load_dwordx4 v1, s[12:15], s20 offen offset:1024 nt lds
    s_cmp_eq_u32 s30, 63
    s_cselect_b32 s35, 129024, s35
    s_cselect_b32 s34, s40, s41
    s_add_u32 m0, s27, 3072
    s_waitcnt vmcnt(18)
    buffer_load_dwordx4 v2, s[12:15], s20 offen offset:2048 nt lds
    s_add_u32 s35, s35, s31
    s_add_u32 s21, s21, 1
    s_add_u32 s22, s27, 6144
    s_cmp_ge_u32 s22, 73728
    s_cselect_b32 s22, 0, s22
    s_mov_b32 m0, s27
    s_waitcnt vmcnt(18)
    buffer_load_dwordx4 v1, s[12:15], s20 offen offset:2048 nt lds
    s_mov_b32 s20, s35
    v_add_u32 v2, s34, v1
    s_mov_b32 s27, s22
    s_add_u32 s23, s23, 1
    s_cmp_lg_u32 s23, s43
    s_cbranch_scc1 L_ld
L_state:
    s_add_u32 s42, s42, 1
    s_cmp_eq_u32 s42, 6
    s_cbranch_scc1 L_done
    s_cmp_eq_u32 s42, 3
    s_cbranch_scc0 L_st1
    s_add_u32 s12, s6, s9
    s_addc_u32 s13, s7, 0
    s_movk_i32 s43, 268
    s_branch L_ld
L_st1:
    s_memrealtime s[50:51]
    s_cmp_eq_u32 s42, 1
    s_cselect_b32 s43, 76, 0
    s_cmp_eq_u32 s42, 4
    s_cselect_b32 s43, 332, s43
    s_waitcnt lgkmcnt(0)
    s_cmp_lg_u32 s43, 0
    s_cbranch_scc0 L_st2
    s_mov_b32 s52, s50
    s_branch L_ld
L_st2:
    s_cmp_eq_u32 s42, 2
    s_movk_i32 s43, 252
    s_cbranch_scc1 L_st3
    s_movk_i32 s43, 508
L_st3:
    s_sub_u32 s50, s50, s52
    s_cmp_lt_u32 s50, 1390
    s_cbranch_scc1 L_ld
    s_cmp_lt_u32 s2, 171
    s_cbranch_scc1 L_ld
L_ldx:
    s_add_u32 m0, s27, 3072
    s_waitcnt vmcnt(21)
    buffer_load_dwordx4 v2, s[12:15], s20 offen offset:0 nt lds
    s_and_b32 s30, s21, 63
    s_bfe_u32 s31, s21, 0x20006
    s_mul_i32 s31, s31, 393216
    s_mul_i32 s35, s30, 3072
    s_mov_b32 m0, s27
    s_waitcnt vmcnt(21)
    buffer_load_dwordx4 v1, s[12:15], s20 offen offset:0 nt lds
    s_cmp_ge_u32 s30, 21
    s_cselect_b32 s34, 67584, 0
    s_add_u32 s35, s35, s34
    s_add_u32 m0, s27, 3072
    s_waitcnt vmcnt(21)
    buffer_load_dwordx4 v2, s[12:15], s20 offen offset:1024 nt lds
    s_cmp_ge_u32 s30, 42
    s_cselect_b32 s34, 67584, 0
    s_add_u32 s35, s35, s34
    s_mov_b32 m0, s27
    s_waitcnt vmcnt(21)
    buffer_load_dwordx4 v1, s[12:15], s20 offen offset:1024 nt lds
    s_and_b32 s28, s23, 0x80000003
    s_cmp_lg_u32 s28, 3
    s_cbranch_scc1 L_ldx_nb
    s_barrier
L_ldx_nb:
    s_cmp_eq_u32 s30, 63
    s_cselect_b32 s35, 129024, s35
    s_cselect_b32 s34, s40, s41
    s_add_u32 m0, s27, 3072
    s_waitcnt vmcnt(21)
    buffer_load_dwordx4 v2, s[12:15], s20 offen offset:2048 nt lds
    s_add_u32 s35, s35, s31
    s_add_u32 s21, s21, 1
    s_add_u32 s22, s27, 6144
    s_cmp_ge_u32 s22, 73728
    s_cselect_b32 s22, 0, s22
    s_mov_b32 m0, s27
    s_waitcnt vmcnt(21)
    buffer_load_dwordx4 v1, s[12:15], s20 offen offset:2048 nt lds
    s_mov_b32 s20, s35
    v_add_u32 v2, s34, v1
    s_mov_b32 s27, s22
    s_add_u32 s23, s23, 1
    s_cmp_lg_u32 s23, s43
    s_cbranch_scc1 L_ldx
    s_branch L_state
L_done:
    s_waitcnt vmcnt(0)
    s_barrier
    s_endpgm
L_cons:
    s_sub_u32 s3, s3, 1
    v_lshrrev_b32 v2, 4, v0
    v_and_b32 v3, 15, v0
    v_and_b32 v4, 3, v0
    s_mul_i32 s10, s2, 1536
    v_mul_u32_u24 v5, 384, v4
    v_lshl_add_u32 v5, v2, 4, v5
    s_waitcnt lgkmcnt(0)
    s_add_u32 s12, s36, s10
    s_addc_u32 s13, s37, 0
    s_mov_b32 s14, 1536
    s_mov_b32 s15, 0x20000
    buffer_load_dwordx4 v[8:11], v5, s[12:15], 0 offen offset:0
    buffer_load_dwordx4 v[12:15], v5, s[12:15], 0 offen offset:64
    buffer_load_dwordx4 v[16:19], v5, s[12:15], 0 offen offset:128
    buffer_load_dwordx4 v[20:23], v5, s[12:15], 0 offen offset:192
    buffer_load_dwordx4 v[24:27], v5, s[12:15], 0 offen offset:256
    buffer_load_dwordx4 v[28:31], v5, s[12:15], 0 offen offset:320
    s_add_u32 s16, s38, s10
    s_addc_u32 s17, s39, 0
    s_mov_b32 s18, 1536
    s_mov_b32 s19, 0x20000
    s_mul_i32 s20, s3, 6144
    v_mul_u32_u24 v95, 384, v3
    v_lshl_add_u32 v95, v2, 4, v95
    v_add_u32 v95, s20, v95
    s_mul_i32 s20, s3, 96
    v_lshrrev_b32 v6, 2, v0
    v_mul_u32_u24 v96, 384, v6
    v_lshl_add_u32 v96, v4, 3, v96
    v_add_u32 v96, s20, v96
    v_lshlrev_b32 v98, 6, v4
    v_lshl_add_u32 v98, v2, 4, v98
    v_add_u32 v98, 73728, v98
    s_lshl_b32 s21, s3, 8
    v_add_u32 v97, s21, v98
    v_mul_u32_u24 v104, 384, v4
    v_lshl_add_u32 v104, v2, 3, v104
    v_add_u32 v104, s20, v104
    v_mov_b32 v92, 0xff800000
    v_mov_b32 v93, 0
    v_mov_b32 v56, 0
    v_mov_b32 v57, 0
    v_mov_b32 v58, 0
    v_mov_b32 v59, 0
    v_mov_b32 v60, 0
    v_mov_b32 v61, 0
    v_mov_b32 v62, 0
    v_mov_b32 v63, 0
    v_mov_b32 v64, 0
    v_mov_b32 v65, 0
    v_mov_b32 v66, 0
    v_mov_b32 v67, 0
    s_mov_b32 s27, 0
    s_mov_b32 s22, 64
    s_mov_b32 s24, 0x000f000f
    s_mov_b32 s25, 0x000f000f
    s_mov_b32 s26, 0x3dd53b95
    s_waitcnt vmcnt(0)
L_kc:
    s_barrier
    v_add_u32 v99, s27, v95
    ds_read_b128 v[32:35], v99 offset:0
    ds_read_b128 v[36:39], v99 offset:64
    ds_read_b128 v[40:43], v99 offset:128
    ds_read_b128 v[44:47], v99 offset:192
    ds_read_b128 v[48:51], v99 offset:256
    ds_read_b128 v[52:55], v99 offset:320
    s_add_u32 s27, s27, 24576
    s_cmp_ge_u32 s27, 73728
    s_cselect_b32 s27, 0, s27
    s_waitcnt lgkmcnt(5)
    v_mfma_f32_16x16x32_bf16 v[68:71], v[32:35], v[8:11], 0
    s_waitcnt lgkmcnt(4)
    v_mfma_f32_16x16x32_bf16 v[68:71], v[36:39], v[12:15], v[68:71]
    s_waitcnt lgkmcnt(3)
    v_mfma_f32_16x16x32_bf16 v[68:71], v[40:43], v[16:19], v[68:71]
    s_waitcnt lgkmcnt(2)
    v_mfma_f32_16x16x32_bf16 v[68:71], v[44:47], v[20:23], v[68:71]
    s_waitcnt lgkmcnt(1)
    v_mfma_f32_16x16x32_bf16 v[68:71], v[48:51], v[24:27], v[68:71]
    s_waitcnt lgkmcnt(0)
    v_mfma_f32_16x16x32_bf16 v[68:71], v[52:55], v[28:31], v[68:71]
    s_sub_u32 s22, s22, 1
    s_nop 7
    s_mov_b64 exec, s[24:25]
    ds_write_b128 v97, v[68:71]
    s_mov_b64 exec, -1
    v_max3_f32 v92, v68, v69, v92
    v_max3_f32 v92, v70, v71, v92
    v_add_u32 v97, 0x400, v97
    s_cmp_lg_u32 s22, 0
    s_cbranch_scc1 L_kc
    v_mov_b32 v100, v92
    s_nop 1
    v_permlane32_swap_b32 v92, v100
    s_nop 1
    v_max_f32 v92, v92, v100
    v_mov_b32 v100, v92
    s_nop 1
    v_permlane16_swap_b32 v92, v100
    s_nop 1
    v_max_f32 v92, v92, v100
    v_lshlrev_b32 v101, 4, v4
    v_add_u32 v101, 139264, v101
    s_lshl_b32 s20, s3, 2
    v_add_u32 v102, s20, v101
    ds_write_b32 v102, v92
    s_mov_b32 s22, 64
    s_waitcnt lgkmcnt(0)
    s_barrier
    ds_read_b128 v[100:103], v101
    ds_read_b128 v[68:71], v98 offset:0
    ds_read_b128 v[72:75], v98 offset:256
    ds_read_b128 v[76:79], v98 offset:512
    ds_read_b128 v[80:83], v98 offset:768
    v_add_u32 v98, 0x400, v98
    s_waitcnt lgkmcnt(4)
    v_max3_f32 v92, v100, v101, v102
    v_max_f32 v92, v92, v103
    v_mul_f32 v94, s26, v92
    s_waitcnt lgkmcnt(0)
    v_fma_f32 v68, v68, s26, -v94
    v_fma_f32 v69, v69, s26, -v94
    v_fma_f32 v70, v70, s26, -v94
    v_fma_f32 v71, v71, s26, -v94
    v_fma_f32 v72, v72, s26, -v94
    v_fma_f32 v73, v73, s26, -v94
    v_fma_f32 v74, v74, s26, -v94
    v_fma_f32 v75, v75, s26, -v94
    v_fma_f32 v76, v76, s26, -v94
    v_fma_f32 v77, v77, s26, -v94
    v_fma_f32 v78, v78, s26, -v94
    v_fma_f32 v79, v79, s26, -v94
    v_fma_f32 v80, v80, s26, -v94
    v_fma_f32 v81, v81, s26, -v94
    v_fma_f32 v82, v82, s26, -v94
    v_fma_f32 v83, v83, s26, -v94
    v_exp_f32 v68, v68
    v_exp_f32 v69, v69
    v_exp_f32 v70, v70
    v_exp_f32 v71, v71
    v_exp_f32 v72, v72
    v_exp_f32 v73, v73
    v_exp_f32 v74, v74
    v_exp_f32 v75, v75
    v_exp_f32 v76, v76
    v_exp_f32 v77, v77
    v_exp_f32 v78, v78
    v_exp_f32 v79, v79
    v_exp_f32 v80, v80
    v_exp_f32 v81, v81
    v_exp_f32 v82, v82
    v_exp_f32 v83, v83
    s_nop 0
    v_cvt_pk_bf16_f32 v84, v68, v69
    v_cvt_pk_bf16_f32 v85, v70, v71
    v_cvt_pk_bf16_f32 v86, v72, v73
    v_cvt_pk_bf16_f32 v87, v74, v75
    v_cvt_pk_bf16_f32 v88, v76, v77
    v_cvt_pk_bf16_f32 v89, v78, v79
    v_cvt_pk_bf16_f32 v90, v80, v81
    v_cvt_pk_bf16_f32 v91, v82, v83
    v_add_f32 v68, v68, v69
    v_add_f32 v70, v70, v71
    v_add_f32 v72, v72, v73
    v_add_f32 v74, v74, v75
    v_add_f32 v76, v76, v77
    v_add_f32 v78, v78, v79
    v_add_f32 v80, v80, v81
    v_add_f32 v82, v82, v83
    v_add_f32 v68, v68, v70
    v_add_f32 v72, v72, v74
    v_add_f32 v76, v76, v78
    v_add_f32 v80, v80, v82
    v_add_f32 v68, v68, v72
    v_add_f32 v76, v76, v80
    v_add_f32 v93, v93, v68
    v_add_f32 v93, v93, v76
    s_branch L_v1st
L_vc:
    s_barrier
L_v1st:
    v_add_u32 v99, s27, v96
    ds_read_b64_tr_b16 v[32:33], v99 offset:0
    ds_read_b64_tr_b16 v[34:35], v99 offset:6144
    ds_read_b64_tr_b16 v[36:37], v99 offset:32
    ds_read_b64_tr_b16 v[38:39], v99 offset:6176
    ds_read_b64_tr_b16 v[40:41], v99 offset:64
    ds_read_b64_tr_b16 v[42:43], v99 offset:6208
    ds_read_b64_tr_b16 v[44:45], v99 offset:12288
    ds_read_b64_tr_b16 v[46:47], v99 offset:18432
    ds_read_b64_tr_b16 v[48:49], v99 offset:12320
    ds_read_b64_tr_b16 v[50:51], v99 offset:18464
    ds_read_b64_tr_b16 v[52:53], v99 offset:12352
    ds_read_b64_tr_b16 v[54:55], v99 offset:18496
    s_add_u32 s27, s27, 24576
    s_cmp_ge_u32 s27, 73728
    s_cselect_b32 s27, 0, s27
    s_sub_u32 s22, s22, 1
    s_waitcnt lgkmcnt(10)
    v_mfma_f32_16x16x32_bf16 v[56:59], v[32:35], v[84:87], v[56:59]
    s_waitcnt lgkmcnt(8)
    v_mfma_f32_16x16x32_bf16 v[60:63], v[36:39], v[84:87], v[60:63]
    s_waitcnt lgkmcnt(6)
    v_mfma_f32_16x16x32_bf16 v[64:67], v[40:43], v[84:87], v[64:67]
    s_waitcnt lgkmcnt(4)
    v_mfma_f32_16x16x32_bf16 v[56:59], v[44:47], v[88:91], v[56:59]
    s_waitcnt lgkmcnt(2)
    v_mfma_f32_16x16x32_bf16 v[60:63], v[48:51], v[88:91], v[60:63]
    s_waitcnt lgkmcnt(0)
    v_mfma_f32_16x16x32_bf16 v[64:67], v[52:55], v[88:91], v[64:67]
    s_cmp_eq_u32 s22, 0
    s_cbranch_scc1 L_vdone
    ds_read_b128 v[68:71], v98 offset:0
    ds_read_b128 v[72:75], v98 offset:256
    ds_read_b128 v[76:79], v98 offset:512
    ds_read_b128 v[80:83], v98 offset:768
    v_add_u32 v98, 0x400, v98
    s_waitcnt lgkmcnt(0)
    v_fma_f32 v68, v68, s26, -v94
    v_fma_f32 v69, v69, s26, -v94
    v_fma_f32 v70, v70, s26, -v94
    v_fma_f32 v71, v71, s26, -v94
    v_fma_f32 v72, v72, s26, -v94
    v_fma_f32 v73, v73, s26, -v94
    v_fma_f32 v74, v74, s26, -v94
    v_fma_f32 v75, v75, s26, -v94
    v_fma_f32 v76, v76, s26, -v94
    v_fma_f32 v77, v77, s26, -v94
    v_fma_f32 v78, v78, s26, -v94
    v_fma_f32 v79, v79, s26, -v94
    v_fma_f32 v80, v80, s26, -v94
    v_fma_f32 v81, v81, s26, -v94
    v_fma_f32 v82, v82, s26, -v94
    v_fma_f32 v83, v83, s26, -v94
    v_exp_f32 v68, v68
    v_exp_f32 v69, v69
    v_exp_f32 v70, v70
    v_exp_f32 v71, v71
    v_exp_f32 v72, v72
    v_exp_f32 v73, v73
    v_exp_f32 v74, v74
    v_exp_f32 v75, v75
    v_exp_f32 v76, v76
    v_exp_f32 v77, v77
    v_exp_f32 v78, v78
    v_exp_f32 v79, v79
    v_exp_f32 v80, v80
    v_exp_f32 v81, v81
    v_exp_f32 v82, v82
    v_exp_f32 v83, v83
    s_nop 0
    v_cvt_pk_bf16_f32 v84, v68, v69
    v_cvt_pk_bf16_f32 v85, v70, v71
    v_cvt_pk_bf16_f32 v86, v72, v73
    v_cvt_pk_bf16_f32 v87, v74, v75
    v_cvt_pk_bf16_f32 v88, v76, v77
    v_cvt_pk_bf16_f32 v89, v78, v79
    v_cvt_pk_bf16_f32 v90, v80, v81
    v_cvt_pk_bf16_f32 v91, v82, v83
    v_add_f32 v68, v68, v69
    v_add_f32 v70, v70, v71
    v_add_f32 v72, v72, v73
    v_add_f32 v74, v74, v75
    v_add_f32 v76, v76, v77
    v_add_f32 v78, v78, v79
    v_add_f32 v80, v80, v81
    v_add_f32 v82, v82, v83
    v_add_f32 v68, v68, v70
    v_add_f32 v72, v72, v74
    v_add_f32 v76, v76, v78
    v_add_f32 v80, v80, v82
    v_add_f32 v68, v68, v72
    v_add_f32 v76, v76, v80
    v_add_f32 v93, v93, v68
    v_add_f32 v93, v93, v76
    s_branch L_vc
L_vdone:
    v_mov_b32 v100, v93
    s_nop 1
    v_permlane32_swap_b32 v93, v100
    s_nop 1
    v_add_f32 v93, v93, v100
    v_mov_b32 v100, v93
    s_nop 1
    v_permlane16_swap_b32 v93, v100
    s_nop 1
    v_add_f32 v93, v93, v100
    v_rcp_f32 v93, v93
    s_mov_b64 exec, s[24:25]
    v_mul_f32 v56, v56, v93
    v_mul_f32 v57, v57, v93
    v_mul_f32 v58, v58, v93
    v_mul_f32 v59, v59, v93
    v_mul_f32 v60, v60, v93
    v_mul_f32 v61, v61, v93
    v_mul_f32 v62, v62, v93
    v_mul_f32 v63, v63, v93
    v_mul_f32 v64, v64, v93
    v_mul_f32 v65, v65, v93
    v_mul_f32 v66, v66, v93
    v_mul_f32 v67, v67, v93
    v_cvt_pk_bf16_f32 v32, v56, v57
    v_cvt_pk_bf16_f32 v33, v58, v59
    v_cvt_pk_bf16_f32 v34, v60, v61
    v_cvt_pk_bf16_f32 v35, v62, v63
    v_cvt_pk_bf16_f32 v36, v64, v65
    v_cvt_pk_bf16_f32 v37, v66, v67
    buffer_store_dwordx2 v[32:33], v104, s[16:19], 0 offen offset:0
    buffer_store_dwordx2 v[34:35], v104, s[16:19], 0 offen offset:32
    buffer_store_dwordx2 v[36:37], v104, s[16:19], 0 offen offset:64
    s_mov_b64 exec, -1
L_end:
    s_endpgm
.section .rodata,"a"
.p2align 6
.amdhsa_kernel standalone__mha_softmax__sampling_kernel
  .amdhsa_next_free_vgpr 112
  .amdhsa_next_free_sgpr 64
  .amdhsa_accum_offset 112
  .amdhsa_group_segment_fixed_size 0
  .amdhsa_kernarg_size 48
  .amdhsa_user_sgpr_count 2
  .amdhsa_user_sgpr_kernarg_segment_ptr 1
  .amdhsa_system_sgpr_workgroup_id_x 1
.end_amdhsa_kernel
```
